```python
import torch

def _softmax(x, axis=-1):
    return torch.softmax(x, dim=axis)

def _gelu(x):
    return torch.nn.functional.gelu(x, approximate='tanh')

def _silu(x):
    return torch.nn.functional.silu(x)

def _sigmoid(x):
    return torch.sigmoid(x)

def _layernorm(x, axis=-1, eps=1e-05):
    m = x.mean(dim=axis, keepdim=True)
    v = x.var(dim=axis, keepdim=True, unbiased=False)
    return (x - m) / torch.sqrt(v + eps)

def _scatter_add(tgt, idx, src, axis=0):
    return tgt.clone().index_add_(axis, idx, src)

def _segment_sum(src, seg, n):
    out = torch.zeros((n,) + src.shape[1:], dtype=src.dtype)
    return out.index_add_(0, seg, src)

def _pad(x, pw):
    flat = tuple((v for pair in reversed(pw) for v in pair))
    return torch.nn.functional.pad(x, flat)
kernel_name = 'standalone__tree_speculative_verify_tree_attention_over_candidate_token_tree__decode'

def setup_inputs():

    _w = lambda a: (lambda t: t.to(torch.bfloat16) if t.is_floating_point() else t)(torch.as_tensor(a))
    B, Hq, Hkv, T, C, D = (2, 32, 16, 1, 32768, 128)
    tree_mask = torch.zeros((B, T, T), dtype=float)
    for b in range(B):
        parent = torch.zeros(T, dtype=torch.int64)
        for i in range(1, T):
            parent[i] = int(torch.randint(0, i, (1,)).item())
        for i in range(T):
            j = i
            tree_mask[b, i, j] = 1.0
            while j > 0:
                j = parent[j]
                tree_mask[b, i, j] = 1.0
    return {'q': _w((lambda *s: torch.randn(*s, dtype=torch.bfloat16) * 0.8)(B, Hq, T, D)), 'k_cache': _w((lambda *s: torch.randn(*s, dtype=torch.bfloat16) * 0.8)(B, Hkv, C, D)), 'v_cache': _w((lambda *s: torch.randn(*s, dtype=torch.bfloat16) * 0.05)(B, Hkv, C, D)), 'k_tree': _w((lambda *s: torch.randn(*s, dtype=torch.bfloat16) * 0.8)(B, Hkv, T, D)), 'v_tree': _w((lambda *s: torch.randn(*s, dtype=torch.bfloat16) * 0.05)(B, Hkv, T, D)), 'tree_mask': _w(tree_mask)}

def reference(q, k_cache, v_cache, k_tree, v_tree, tree_mask):
    B, Hq, T, D = q.shape
    Hkv, C = (k_cache.shape[1], k_cache.shape[2])
    rep = Hq // Hkv
    kc = (lambda x, n, axis: torch.repeat_interleave(x, n, dim=axis))(k_cache, rep, axis=1)
    vc = (lambda x, n, axis: torch.repeat_interleave(x, n, dim=axis))(v_cache, rep, axis=1)
    kt = (lambda x, n, axis: torch.repeat_interleave(x, n, dim=axis))(k_tree, rep, axis=1)
    vt = (lambda x, n, axis: torch.repeat_interleave(x, n, dim=axis))(v_tree, rep, axis=1)
    k = torch.concatenate([kc, kt], axis=2)
    v = torch.concatenate([vc, vt], axis=2)
    scale = D ** (-0.5)
    scores = torch.einsum('bhqd,bhkd->bhqk', q, k) * scale
    ctx_mask = torch.ones((B, 1, T, C), dtype=scores.dtype)
    tm = tree_mask[:, None, :, :].clone()
    full_mask = torch.concatenate([ctx_mask, tm], axis=-1)
    scores = scores + (1.0 - full_mask) * -1000000000.0
    p = _softmax(scores, axis=-1)
    return torch.einsum('bhqk,bhkd->bhqd', p, v)
```

```asm
; @launch grid=(256,1,1) block=(320,1,1) lds=40192
.amdgcn_target "amdgcn-amd-amdhsa--gfx950"
.text
.globl standalone__tree_speculative_verify_tree_attention_over_candidate_token_tree__decode_kernel
.p2align 8
.type standalone__tree_speculative_verify_tree_attention_over_candidate_token_tree__decode_kernel,@function
standalone__tree_speculative_verify_tree_attention_over_candidate_token_tree__decode_kernel:
    s_cmp_ge_u32 s2, 256
    s_cbranch_scc1 L_end
    s_load_dwordx16 s[4:19], s[0:1], 0
    s_load_dwordx2 s[20:21], s[0:1], 64
    v_lshrrev_b32 v13, 6, v0
    s_and_b32 s33, s2, 7
    s_lshr_b32 s32, s2, 3
    v_readfirstlane_b32 s34, v13
    v_bfe_u32 v11, v0, 4, 2
    s_lshl_b32 s39, s32, 9
    v_bfe_u32 v12, v0, 3, 1
    v_lshl_add_u32 v12, v12, 8, s39
    s_cmp_eq_u32 s34, 4
    s_cbranch_scc1 L_help
    s_cmp_eq_u32 s34, 1
    s_cselect_b32 s47, 0x100, 0
    s_cmp_eq_u32 s34, 2
    s_cselect_b32 s47, 0x10300, s47
    s_cmp_eq_u32 s34, 3
    s_cselect_b32 s47, 0x10200, s47
    s_bitcmp1_b32 s2, 0
    s_cselect_b32 s38, 0x3200, 0
    s_xor_b32 s47, s47, s38
    s_bitcmp1_b32 s2, 1
    s_cselect_b32 s38, 0x202100, 0
    s_xor_b32 s47, s47, s38
    s_bitcmp1_b32 s2, 2
    s_cselect_b32 s38, 0x4400, 0
    s_xor_b32 s47, s47, s38
    s_bitcmp1_b32 s2, 3
    s_cselect_b32 s38, 0x202000, 0
    s_xor_b32 s47, s47, s38
    s_bitcmp1_b32 s2, 4
    s_cselect_b32 s38, 0x1400, 0
    s_xor_b32 s47, s47, s38
    s_bitcmp1_b32 s2, 5
    s_cselect_b32 s38, 0x1800, 0
    s_xor_b32 s47, s47, s38
    s_bitcmp1_b32 s2, 6
    s_cselect_b32 s38, 0x4400, 0
    s_xor_b32 s47, s47, s38
    s_bitcmp1_b32 s2, 7
    s_cselect_b32 s38, 0x1300, 0
    s_xor_b32 s47, s47, s38
    v_and_b32 v10, 3, v0
    v_lshlrev_b32 v10, 4, v10
    v_lshl_add_u32 v48, v11, 6, v10
    v_add_u32 v12, v12, v48
    v_bfe_i32 v2, v0, 2, 1
    v_and_b32 v2, 0x9900, v2
    v_xor_b32 v48, v48, v2
    v_bfe_i32 v2, v0, 3, 1
    v_and_b32 v2, 0x800, v2
    v_xor_b32 v48, v48, v2
    v_xor_b32 v49, 0x6200, v48
    v_xor_b32 v50, 0x1000, v48
    v_xor_b32 v51, 0x1000, v49
    s_mov_b32 s35, s47
    s_lshl_b32 s38, s32, 23
    s_mov_b32 s26, 0x800000
    s_mov_b32 s27, 0x20000
    v_xor_b32 v56, s35, v48
    v_xor_b32 v57, s35, v49
    v_xor_b32 v58, s35, v50
    v_xor_b32 v59, s35, v51
    s_waitcnt lgkmcnt(0)
    s_add_u32 s24, s6, s38
    s_addc_u32 s25, s7, 0
    buffer_load_dwordx4 v[64:67], v56, s[24:27], 0 offen nt
    buffer_load_dwordx4 v[68:71], v57, s[24:27], 0 offen nt
    buffer_load_dwordx4 v[72:75], v58, s[24:27], 0 offen nt
    buffer_load_dwordx4 v[76:79], v59, s[24:27], 0 offen nt
    global_load_dwordx4 v[24:27], v12, s[4:5]
    s_add_u32 s8, s8, s38
    s_addc_u32 s9, s9, 0
    s_mov_b32 s31, 0x92400
    s_cmp_eq_u32 s34, 2
    s_cselect_b32 s31, 0x290500, s31
    s_xor_b32 s35, s35, s31
    v_xor_b32 v60, s35, v48
    v_xor_b32 v61, s35, v49
    v_xor_b32 v62, s35, v50
    v_xor_b32 v63, s35, v51
    buffer_load_dwordx4 v[80:83], v60, s[24:27], 0 offen nt
    buffer_load_dwordx4 v[84:87], v61, s[24:27], 0 offen nt
    buffer_load_dwordx4 v[88:91], v62, s[24:27], 0 offen nt
    buffer_load_dwordx4 v[92:95], v63, s[24:27], 0 offen nt
    s_xor_b32 s35, s35, s31
    s_xor_b32 s35, s35, 0x202200
    v_xor_b32 v56, s35, v48
    v_xor_b32 v57, s35, v49
    v_xor_b32 v58, s35, v50
    v_xor_b32 v59, s35, v51
    buffer_load_dwordx4 v[96:99], v56, s[24:27], 0 offen nt
    buffer_load_dwordx4 v[100:103], v57, s[24:27], 0 offen nt
    buffer_load_dwordx4 v[104:107], v58, s[24:27], 0 offen nt
    buffer_load_dwordx4 v[108:111], v59, s[24:27], 0 offen nt
    s_xor_b32 s35, s35, s31
    v_xor_b32 v60, s35, v48
    v_xor_b32 v61, s35, v49
    v_xor_b32 v62, s35, v50
    v_xor_b32 v63, s35, v51
    buffer_load_dwordx4 v[112:115], v60, s[24:27], 0 offen nt
    buffer_load_dwordx4 v[116:119], v61, s[24:27], 0 offen nt
    buffer_load_dwordx4 v[120:123], v62, s[24:27], 0 offen nt
    buffer_load_dwordx4 v[124:127], v63, s[24:27], 0 offen nt
    v_and_b32 v52, 15, v0
    v_lshlrev_b32 v52, 4, v52
    v_bfe_i32 v2, v0, 4, 1
    v_and_b32 v2, 0x9900, v2
    v_xor_b32 v52, v52, v2
    v_bfe_i32 v2, v0, 5, 1
    v_and_b32 v2, 0x800, v2
    v_xor_b32 v52, v52, v2
    v_xor_b32 v53, 0x6200, v52
    v_xor_b32 v54, 0x1000, v52
    v_xor_b32 v55, 0x1000, v53
    s_mov_b32 s40, 1
    s_mov_b32 s3, 0x3db504f3
    s_mov_b32 s36, 0x3fb8aa3b
    s_mov_b32 s22, 0x01010101
    s_mov_b32 s23, 0x01010101
    s_lshl_b32 s38, s32, 8
    s_add_u32 s38, s38, 1048576
    s_add_u32 s50, s20, s38
    s_addc_u32 s51, s21, 0
    s_mov_b32 s42, 1
    s_lshl_b32 s38, s34, 13
    s_add_u32 s38, s38, 7424
    v_bfe_u32 v1, v0, 3, 1
    v_lshl_add_u32 v1, v1, 6, s38
    v_lshl_add_u32 v1, v11, 4, v1
    v_lshlrev_b32 v3, 2, v0
    v_and_b32 v0, 63, v0
    v_mov_b32 v8, 0xff800000
    v_mov_b32 v9, 0
    v_mov_b32 v4, 0
    v_mov_b32 v5, 0
    v_mov_b32 v6, 0
    v_mov_b32 v7, 0
    v_and_b32 v10, 1, v0
    v_lshlrev_b32 v10, 4, v10
    v_mov_b32 v12, 0xffff
    v_lshlrev_b32 v12, v10, v12
    v_bfe_u32 v10, v0, 1, 2
    v_cmp_eq_u32 vcc, 0, v10
    s_nop 1
    v_cndmask_b32 v28, 0, v12, vcc
    v_cmp_eq_u32 vcc, 1, v10
    s_nop 1
    v_cndmask_b32 v29, 0, v12, vcc
    v_cmp_eq_u32 vcc, 2, v10
    s_nop 1
    v_cndmask_b32 v30, 0, v12, vcc
    v_cmp_eq_u32 vcc, 3, v10
    s_nop 1
    v_cndmask_b32 v31, 0, v12, vcc
    s_mov_b32 s43, 0
    s_mov_b32 s46, 3
    s_mov_b32 s37, 0
    s_branch L_kloop
L_help:
    s_setprio 3
    v_lshl_add_u32 v12, v11, 4, v12
    v_and_b32 v0, 63, v0
    v_mov_b32 v8, 0xff800000
    v_mov_b32 v4, 0
    v_mov_b32 v5, 0
    v_mov_b32 v6, 0
    v_mov_b32 v7, 0
    v_mov_b32 v32, -1
    v_mov_b32 v33, -1
    v_mov_b32 v34, -1
    v_mov_b32 v35, -1
    s_mov_b32 s36, 0x3fb8aa3b
    s_lshl_b32 s38, s2, 10
    v_lshl_add_u32 v14, v0, 4, s38
    s_lshl_b32 s38, s32, 8
    s_lshl_b32 s45, s33, 4
    s_add_u32 s45, s45, s38
    s_add_u32 s45, s45, 524288
    v_mov_b32 v15, s45
    s_waitcnt lgkmcnt(0)
    global_store_dwordx4 v14, v[32:35], s[20:21] sc1
    s_mov_b64 exec, 1
    global_store_dwordx4 v15, v[32:35], s[20:21] sc1
    s_mov_b64 exec, -1
    s_cmp_lg_u32 s2, 0
    s_cbranch_scc1 L_noinit
    v_and_b32 v10, 31, v0
    v_lshlrev_b32 v10, 8, v10
    v_add_u32 v10, 1048576, v10
    global_store_dwordx4 v10, v[4:7], s[20:21] sc1
    v_mov_b32 v13, 1
    s_waitcnt vmcnt(0)
    global_store_dword v4, v13, s[18:19] sc1
L_noinit:
    s_and_b32 s45, s32, 7
    s_cmp_lg_u32 s33, s45
    s_cbranch_scc1 L_notree
    s_lshr_b32 s45, s32, 4
    s_lshl_b32 s45, s45, 1
    v_lshl_add_u32 v10, v11, 4, s38
    v_and_b32 v8, 7, v0
    v_lshl_add_u32 v8, v8, 1, s38
    v_lshl_add_u32 v8, v11, 6, v8
    v_mov_b32 v9, s45
    global_load_dwordx4 v[64:67], v12, s[4:5] offset:0
    global_load_dwordx4 v[68:71], v12, s[4:5] offset:64
    global_load_dwordx4 v[72:75], v12, s[4:5] offset:128
    global_load_dwordx4 v[76:79], v12, s[4:5] offset:192
    global_load_dwordx4 v[80:83], v10, s[10:11] offset:0
    global_load_dwordx4 v[84:87], v10, s[10:11] offset:64
    global_load_dwordx4 v[88:91], v10, s[10:11] offset:128
    global_load_dwordx4 v[92:95], v10, s[10:11] offset:192
    global_load_ushort v4, v8, s[12:13] offset:0
    global_load_ushort v5, v8, s[12:13] offset:16
    global_load_ushort v6, v8, s[12:13] offset:32
    global_load_ushort v7, v8, s[12:13] offset:48
    global_load_ushort v13, v9, s[14:15]
    s_waitcnt vmcnt(0)
    v_mfma_f32_16x16x32_bf16 v[16:19], v[80:83], v[64:67], 0
    v_mfma_f32_16x16x32_bf16 v[16:19], v[84:87], v[68:71], v[16:19]
    v_mfma_f32_16x16x32_bf16 v[16:19], v[88:91], v[72:75], v[16:19]
    v_mfma_f32_16x16x32_bf16 v[16:19], v[92:95], v[76:79], v[16:19]
    v_lshlrev_b32 v4, 16, v4
    v_lshlrev_b32 v5, 16, v5
    v_lshlrev_b32 v6, 16, v6
    v_lshlrev_b32 v7, 16, v7
    v_lshlrev_b32 v13, 16, v13
    v_sub_f32 v13, 1.0, v13
    s_nop 1
    v_cvt_pk_bf16_f32 v13, v16, v13
    v_lshlrev_b32 v8, 16, v13
    v_and_b32 v13, 0xffff0000, v13
    v_mul_f32 v8, 0x3db504f3, v8
    v_mul_f32 v13, 0xce6e6b28, v13
    v_cvt_pk_bf16_f32 v13, v8, v13
    v_lshlrev_b32 v8, 16, v13
    v_and_b32 v13, 0xffff0000, v13
    v_add_f32 v8, v8, v13
    v_cvt_pk_bf16_f32 v8, v8, v8
    v_lshlrev_b32 v8, 16, v8
    v_mul_f32 v8, s36, v8
L_notree:
    v_lshlrev_b32 v10, 2, v0
    v_lshlrev_b32 v11, 4, v0
    ds_write_b32 v10, v8 offset:1024
    ds_write_b128 v11, v[4:7] offset:1280
    s_waitcnt vmcnt(0) lgkmcnt(0)
    s_branch L_end
L_kloop:
    s_cmp_lg_u32 s37, 15
    s_cbranch_scc1 L_kgo
    s_mov_b32 s24, s8
    s_mov_b32 s25, s9
    s_mov_b32 s40, 0
    v_mov_b32 v48, v52
    v_mov_b32 v49, v53
    v_mov_b32 v50, v54
    v_mov_b32 v51, v55
L_kgo:
    s_bitcmp1_b32 s40, 0
    s_cselect_b32 s38, 0x494700, 0
    s_xor_b32 s35, s47, s38
    s_bitcmp1_b32 s40, 1
    s_cselect_b32 s38, 0x100100, 0
    s_xor_b32 s35, s35, s38
    s_bitcmp1_b32 s40, 2
    s_cselect_b32 s38, 0x20400, 0
    s_xor_b32 s35, s35, s38
    s_bitcmp1_b32 s40, 3
    s_cselect_b32 s38, 0x40800, 0
    s_xor_b32 s35, s35, s38
    s_add_u32 s40, s40, 1
    s_cmp_lg_u32 s37, 8
    s_cbranch_scc1 L_p0
    s_load_dword s44, s[18:19], 0
L_p0:
    s_xor_b32 s38, s37, 15
    s_or_b32 s38, s38, s34
    s_cbranch_scc1 L_p1
    s_waitcnt lgkmcnt(0)
    v_mov_b32 v10, s46
    ds_write_b32 v3, v10 offset:6400
    s_waitcnt lgkmcnt(0)
L_p1:
    s_cmp_lt_u32 s37, 4
    s_cbranch_scc1 L_knb0
    s_barrier
L_knb0:
    s_cmp_lg_u32 s37, 15
    s_cbranch_scc1 L_p2
    v_mov_b32 v10, 0
    ds_read_b32 v10, v10 offset:6400
    s_waitcnt lgkmcnt(0)
    v_readfirstlane_b32 s46, v10
L_p2:
    s_cmp_lg_u32 s37, 15
    s_cbranch_scc1 L_rup
    s_waitcnt lgkmcnt(0)
    s_mov_b32 s28, 0x17171717
    s_mov_b32 s29, 0x10307
    s_lshl_b32 s46, s46, 3
    s_lshr_b64 s[28:29], s[28:29], s46
    s_and_b32 s43, s28, 0xff
    s_mul_i32 s43, s43, 0x1
L_rup:
    s_xor_b32 s38, s37, 14
    s_or_b32 s38, s38, s34
    s_cbranch_scc1 L_p3
    s_waitcnt lgkmcnt(0)
    s_cmp_eq_u32 s44, 0
    s_cbranch_scc1 L_p3
    s_mov_b32 s46, 1
    s_atomic_add s46, s[50:51], 4 glc
L_p3:
    v_xor_b32 v56, s35, v48
    v_xor_b32 v57, s35, v49
    v_xor_b32 v58, s35, v50
    v_xor_b32 v59, s35, v51
    s_waitcnt vmcnt(12)
    v_mfma_f32_16x16x32_bf16 v[32:35], v[64:67], v[24:27], 0
    v_mfma_f32_16x16x32_bf16 v[36:39], v[68:71], v[24:27], 0
    v_mfma_f32_16x16x32_bf16 v[40:43], v[72:75], v[24:27], 0
    v_mfma_f32_16x16x32_bf16 v[44:47], v[76:79], v[24:27], 0
    s_bitcmp0_b32 s43, 4
    s_cbranch_scc1 L_zf0
    s_lshr_b32 s43, s43, 1
    s_waitcnt vmcnt(1)
    buffer_load_dwordx4 v[64:67], v56, s[24:27], 0 offen nt
    s_waitcnt vmcnt(1)
    buffer_load_dwordx4 v[68:71], v57, s[24:27], 0 offen nt
    s_waitcnt vmcnt(1)
    buffer_load_dwordx4 v[72:75], v58, s[24:27], 0 offen nt
    s_waitcnt vmcnt(1)
    buffer_load_dwordx4 v[76:79], v59, s[24:27], 0 offen nt
    s_branch L_zg0
L_zf0:
    s_bitcmp0_b32 s43, 0
    s_cbranch_scc1 L_pck0
    s_waitcnt vmcnt(3)
L_pck0:
    s_lshr_b32 s43, s43, 1
    buffer_load_dwordx4 v[64:67], v56, s[24:27], 0 offen nt
    buffer_load_dwordx4 v[68:71], v57, s[24:27], 0 offen nt
    buffer_load_dwordx4 v[72:75], v58, s[24:27], 0 offen nt
    buffer_load_dwordx4 v[76:79], v59, s[24:27], 0 offen nt
L_zg0:
    s_nop 0
    v_add_f32_dpp v16, v33, v32 quad_perm:[1,1,1,1] row_mask:0xf bank_mask:0xf
    v_add_f32_dpp v17, v37, v36 quad_perm:[1,1,1,1] row_mask:0xf bank_mask:0xf
    v_add_f32_dpp v18, v41, v40 quad_perm:[1,1,1,1] row_mask:0xf bank_mask:0xf
    v_add_f32_dpp v19, v45, v44 quad_perm:[1,1,1,1] row_mask:0xf bank_mask:0xf
    v_add_f32_dpp v16, v34, v16 quad_perm:[2,2,2,2] row_mask:0xf bank_mask:0xf
    v_add_f32_dpp v17, v38, v17 quad_perm:[2,2,2,2] row_mask:0xf bank_mask:0xf
    v_add_f32_dpp v18, v42, v18 quad_perm:[2,2,2,2] row_mask:0xf bank_mask:0xf
    v_add_f32_dpp v19, v46, v19 quad_perm:[2,2,2,2] row_mask:0xf bank_mask:0xf
    v_add_f32_dpp v16, v35, v16 quad_perm:[3,3,3,3] row_mask:0xf bank_mask:0xf
    v_add_f32_dpp v17, v39, v17 quad_perm:[3,3,3,3] row_mask:0xf bank_mask:0xf
    v_add_f32_dpp v18, v43, v18 quad_perm:[3,3,3,3] row_mask:0xf bank_mask:0xf
    v_add_f32_dpp v19, v47, v19 quad_perm:[3,3,3,3] row_mask:0xf bank_mask:0xf
    v_cvt_pk_bf16_f32 v17, v16, v17
    v_cvt_pk_bf16_f32 v19, v18, v19
    v_lshlrev_b32 v16, 16, v17
    v_and_b32 v17, 0xffff0000, v17
    v_lshlrev_b32 v18, 16, v19
    v_and_b32 v19, 0xffff0000, v19
    v_mul_f32 v16, s3, v16
    v_mul_f32 v17, s3, v17
    v_mul_f32 v18, s3, v18
    v_mul_f32 v19, s3, v19
    v_cvt_pk_bf16_f32 v17, v16, v17
    v_cvt_pk_bf16_f32 v19, v18, v19
    v_lshlrev_b32 v16, 16, v17
    v_and_b32 v17, 0xffff0000, v17
    v_lshlrev_b32 v18, 16, v19
    v_and_b32 v19, 0xffff0000, v19
    v_max3_f32 v8, v8, v16, v17
    v_max3_f32 v8, v8, v18, v19
    s_mov_b64 exec, s[22:23]
    ds_write_b128 v1, v[16:19] offset:0
    s_mov_b64 exec, -1
    s_xor_b32 s35, s35, s31
    v_xor_b32 v60, s35, v48
    v_xor_b32 v61, s35, v49
    v_xor_b32 v62, s35, v50
    v_xor_b32 v63, s35, v51
    s_waitcnt vmcnt(12)
    v_mfma_f32_16x16x32_bf16 v[32:35], v[80:83], v[24:27], 0
    v_mfma_f32_16x16x32_bf16 v[36:39], v[84:87], v[24:27], 0
    v_mfma_f32_16x16x32_bf16 v[40:43], v[88:91], v[24:27], 0
    v_mfma_f32_16x16x32_bf16 v[44:47], v[92:95], v[24:27], 0
    s_bitcmp0_b32 s43, 0
    s_cbranch_scc1 L_pck1
    s_waitcnt vmcnt(3)
L_pck1:
    s_lshr_b32 s43, s43, 1
    buffer_load_dwordx4 v[80:83], v60, s[24:27], 0 offen nt
    buffer_load_dwordx4 v[84:87], v61, s[24:27], 0 offen nt
    buffer_load_dwordx4 v[88:91], v62, s[24:27], 0 offen nt
    buffer_load_dwordx4 v[92:95], v63, s[24:27], 0 offen nt
    s_nop 0
    v_add_f32_dpp v20, v33, v32 quad_perm:[1,1,1,1] row_mask:0xf bank_mask:0xf
    v_add_f32_dpp v21, v37, v36 quad_perm:[1,1,1,1] row_mask:0xf bank_mask:0xf
    v_add_f32_dpp v22, v41, v40 quad_perm:[1,1,1,1] row_mask:0xf bank_mask:0xf
    v_add_f32_dpp v23, v45, v44 quad_perm:[1,1,1,1] row_mask:0xf bank_mask:0xf
    v_add_f32_dpp v20, v34, v20 quad_perm:[2,2,2,2] row_mask:0xf bank_mask:0xf
    v_add_f32_dpp v21, v38, v21 quad_perm:[2,2,2,2] row_mask:0xf bank_mask:0xf
    v_add_f32_dpp v22, v42, v22 quad_perm:[2,2,2,2] row_mask:0xf bank_mask:0xf
    v_add_f32_dpp v23, v46, v23 quad_perm:[2,2,2,2] row_mask:0xf bank_mask:0xf
    v_add_f32_dpp v20, v35, v20 quad_perm:[3,3,3,3] row_mask:0xf bank_mask:0xf
    v_add_f32_dpp v21, v39, v21 quad_perm:[3,3,3,3] row_mask:0xf bank_mask:0xf
    v_add_f32_dpp v22, v43, v22 quad_perm:[3,3,3,3] row_mask:0xf bank_mask:0xf
    v_add_f32_dpp v23, v47, v23 quad_perm:[3,3,3,3] row_mask:0xf bank_mask:0xf
    v_cvt_pk_bf16_f32 v21, v20, v21
    v_cvt_pk_bf16_f32 v23, v22, v23
    v_lshlrev_b32 v20, 16, v21
    v_and_b32 v21, 0xffff0000, v21
    v_lshlrev_b32 v22, 16, v23
    v_and_b32 v23, 0xffff0000, v23
    v_mul_f32 v20, s3, v20
    v_mul_f32 v21, s3, v21
    v_mul_f32 v22, s3, v22
    v_mul_f32 v23, s3, v23
    v_cvt_pk_bf16_f32 v21, v20, v21
    v_cvt_pk_bf16_f32 v23, v22, v23
    v_lshlrev_b32 v20, 16, v21
    v_and_b32 v21, 0xffff0000, v21
    v_lshlrev_b32 v22, 16, v23
    v_and_b32 v23, 0xffff0000, v23
    v_max3_f32 v8, v8, v20, v21
    v_max3_f32 v8, v8, v22, v23
    s_mov_b64 exec, s[22:23]
    ds_write_b128 v1, v[20:23] offset:128
    s_mov_b64 exec, -1
    s_xor_b32 s35, s35, s31
    s_xor_b32 s35, s35, 0x202200
    v_xor_b32 v56, s35, v48
    v_xor_b32 v57, s35, v49
    v_xor_b32 v58, s35, v50
    v_xor_b32 v59, s35, v51
    s_waitcnt vmcnt(12)
    v_mfma_f32_16x16x32_bf16 v[32:35], v[96:99], v[24:27], 0
    v_mfma_f32_16x16x32_bf16 v[36:39], v[100:103], v[24:27], 0
    v_mfma_f32_16x16x32_bf16 v[40:43], v[104:107], v[24:27], 0
    v_mfma_f32_16x16x32_bf16 v[44:47], v[108:111], v[24:27], 0
    s_bitcmp0_b32 s43, 0
    s_cbranch_scc1 L_pck2
    s_waitcnt vmcnt(3)
L_pck2:
    s_lshr_b32 s43, s43, 1
    buffer_load_dwordx4 v[96:99], v56, s[24:27], 0 offen nt
    buffer_load_dwordx4 v[100:103], v57, s[24:27], 0 offen nt
    buffer_load_dwordx4 v[104:107], v58, s[24:27], 0 offen nt
    buffer_load_dwordx4 v[108:111], v59, s[24:27], 0 offen nt
    s_nop 0
    v_add_f32_dpp v16, v33, v32 quad_perm:[1,1,1,1] row_mask:0xf bank_mask:0xf
    v_add_f32_dpp v17, v37, v36 quad_perm:[1,1,1,1] row_mask:0xf bank_mask:0xf
    v_add_f32_dpp v18, v41, v40 quad_perm:[1,1,1,1] row_mask:0xf bank_mask:0xf
    v_add_f32_dpp v19, v45, v44 quad_perm:[1,1,1,1] row_mask:0xf bank_mask:0xf
    v_add_f32_dpp v16, v34, v16 quad_perm:[2,2,2,2] row_mask:0xf bank_mask:0xf
    v_add_f32_dpp v17, v38, v17 quad_perm:[2,2,2,2] row_mask:0xf bank_mask:0xf
    v_add_f32_dpp v18, v42, v18 quad_perm:[2,2,2,2] row_mask:0xf bank_mask:0xf
    v_add_f32_dpp v19, v46, v19 quad_perm:[2,2,2,2] row_mask:0xf bank_mask:0xf
    v_add_f32_dpp v16, v35, v16 quad_perm:[3,3,3,3] row_mask:0xf bank_mask:0xf
    v_add_f32_dpp v17, v39, v17 quad_perm:[3,3,3,3] row_mask:0xf bank_mask:0xf
    v_add_f32_dpp v18, v43, v18 quad_perm:[3,3,3,3] row_mask:0xf bank_mask:0xf
    v_add_f32_dpp v19, v47, v19 quad_perm:[3,3,3,3] row_mask:0xf bank_mask:0xf
    v_cvt_pk_bf16_f32 v17, v16, v17
    v_cvt_pk_bf16_f32 v19, v18, v19
    v_lshlrev_b32 v16, 16, v17
    v_and_b32 v17, 0xffff0000, v17
    v_lshlrev_b32 v18, 16, v19
    v_and_b32 v19, 0xffff0000, v19
    v_mul_f32 v16, s3, v16
    v_mul_f32 v17, s3, v17
    v_mul_f32 v18, s3, v18
    v_mul_f32 v19, s3, v19
    v_cvt_pk_bf16_f32 v17, v16, v17
    v_cvt_pk_bf16_f32 v19, v18, v19
    v_lshlrev_b32 v16, 16, v17
    v_and_b32 v17, 0xffff0000, v17
    v_lshlrev_b32 v18, 16, v19
    v_and_b32 v19, 0xffff0000, v19
    v_max3_f32 v8, v8, v16, v17
    v_max3_f32 v8, v8, v18, v19
    s_mov_b64 exec, s[22:23]
    ds_write_b128 v1, v[16:19] offset:256
    s_mov_b64 exec, -1
    s_xor_b32 s35, s35, s31
    v_xor_b32 v60, s35, v48
    v_xor_b32 v61, s35, v49
    v_xor_b32 v62, s35, v50
    v_xor_b32 v63, s35, v51
    s_waitcnt vmcnt(12)
    v_mfma_f32_16x16x32_bf16 v[32:35], v[112:115], v[24:27], 0
    v_mfma_f32_16x16x32_bf16 v[36:39], v[116:119], v[24:27], 0
    v_mfma_f32_16x16x32_bf16 v[40:43], v[120:123], v[24:27], 0
    v_mfma_f32_16x16x32_bf16 v[44:47], v[124:127], v[24:27], 0
    s_bitcmp0_b32 s43, 0
    s_cbranch_scc1 L_pck3
    s_waitcnt vmcnt(3)
L_pck3:
    s_lshr_b32 s43, s43, 1
    buffer_load_dwordx4 v[112:115], v60, s[24:27], 0 offen nt
    buffer_load_dwordx4 v[116:119], v61, s[24:27], 0 offen nt
    buffer_load_dwordx4 v[120:123], v62, s[24:27], 0 offen nt
    buffer_load_dwordx4 v[124:127], v63, s[24:27], 0 offen nt
    s_nop 0
    v_add_f32_dpp v20, v33, v32 quad_perm:[1,1,1,1] row_mask:0xf bank_mask:0xf
    v_add_f32_dpp v21, v37, v36 quad_perm:[1,1,1,1] row_mask:0xf bank_mask:0xf
    v_add_f32_dpp v22, v41, v40 quad_perm:[1,1,1,1] row_mask:0xf bank_mask:0xf
    v_add_f32_dpp v23, v45, v44 quad_perm:[1,1,1,1] row_mask:0xf bank_mask:0xf
    v_add_f32_dpp v20, v34, v20 quad_perm:[2,2,2,2] row_mask:0xf bank_mask:0xf
    v_add_f32_dpp v21, v38, v21 quad_perm:[2,2,2,2] row_mask:0xf bank_mask:0xf
    v_add_f32_dpp v22, v42, v22 quad_perm:[2,2,2,2] row_mask:0xf bank_mask:0xf
    v_add_f32_dpp v23, v46, v23 quad_perm:[2,2,2,2] row_mask:0xf bank_mask:0xf
    v_add_f32_dpp v20, v35, v20 quad_perm:[3,3,3,3] row_mask:0xf bank_mask:0xf
    v_add_f32_dpp v21, v39, v21 quad_perm:[3,3,3,3] row_mask:0xf bank_mask:0xf
    v_add_f32_dpp v22, v43, v22 quad_perm:[3,3,3,3] row_mask:0xf bank_mask:0xf
    v_add_f32_dpp v23, v47, v23 quad_perm:[3,3,3,3] row_mask:0xf bank_mask:0xf
    v_cvt_pk_bf16_f32 v21, v20, v21
    v_cvt_pk_bf16_f32 v23, v22, v23
    v_lshlrev_b32 v20, 16, v21
    v_and_b32 v21, 0xffff0000, v21
    v_lshlrev_b32 v22, 16, v23
    v_and_b32 v23, 0xffff0000, v23
    v_mul_f32 v20, s3, v20
    v_mul_f32 v21, s3, v21
    v_mul_f32 v22, s3, v22
    v_mul_f32 v23, s3, v23
    v_cvt_pk_bf16_f32 v21, v20, v21
    v_cvt_pk_bf16_f32 v23, v22, v23
    v_lshlrev_b32 v20, 16, v21
    v_and_b32 v21, 0xffff0000, v21
    v_lshlrev_b32 v22, 16, v23
    v_and_b32 v23, 0xffff0000, v23
    v_max3_f32 v8, v8, v20, v21
    v_max3_f32 v8, v8, v22, v23
    s_mov_b64 exec, s[22:23]
    ds_write_b128 v1, v[20:23] offset:384
    s_mov_b64 exec, -1
    v_add_u32 v1, 512, v1
    s_add_u32 s37, s37, 1
    s_cmp_lt_u32 s37, 16
    s_cbranch_scc1 L_kloop
    v_subrev_u32 v1, 8192, v1
    v_mov_b32 v11, v8
    s_nop 1
    v_permlane16_swap_b32 v8, v11
    v_max_f32 v8, v8, v11
    v_mov_b32 v11, v8
    s_nop 1
    v_permlane32_swap_b32 v8, v11
    v_max_f32 v8, v8, v11
    v_mul_f32 v11, s36, v8
    v_lshlrev_b32 v10, 2, v0
    v_lshlrev_b32 v2, 4, v0
    v_mov_b32_dpp v8, v11 row_newbcast:0 row_mask:0xf bank_mask:0x3
    s_nop 1
    v_mov_b32_dpp v8, v11 row_newbcast:8 row_mask:0xf bank_mask:0xc
    ds_write_b32 v3, v8 offset:0
    s_waitcnt lgkmcnt(0)
    s_barrier
    ds_read_b32 v32, v10 offset:0
    ds_read_b32 v33, v10 offset:256
    ds_read_b32 v34, v10 offset:512
    ds_read_b32 v35, v10 offset:768
    ds_read_b32 v36, v10 offset:1024
    ds_read_b128 v[40:43], v2 offset:1280
    ds_read_b128 v[16:19], v1
    s_mov_b32 s37, 1
    s_cmp_lg_u32 s34, 0
    s_waitcnt lgkmcnt(1)
    v_max3_f32 v8, v32, v33, v34
    v_max3_f32 v8, v8, v35, v36
    s_cbranch_scc1 L_vloop
    v_sub_f32 v10, v36, v8
    v_exp_f32 v10, v10
    v_cmp_gt_u32 vcc, 16, v0
    v_mul_f32 v4, v10, v40
    v_mul_f32 v5, v10, v41
    v_mul_f32 v6, v10, v42
    v_mul_f32 v7, v10, v43
    v_cndmask_b32 v9, 0, v10, vcc
L_vloop:
    s_bitcmp1_b32 s40, 0
    s_cselect_b32 s38, 0x494700, 0
    s_xor_b32 s35, s47, s38
    s_bitcmp1_b32 s40, 1
    s_cselect_b32 s38, 0x100100, 0
    s_xor_b32 s35, s35, s38
    s_bitcmp1_b32 s40, 2
    s_cselect_b32 s38, 0x20400, 0
    s_xor_b32 s35, s35, s38
    s_bitcmp1_b32 s40, 3
    s_cselect_b32 s38, 0x40800, 0
    s_xor_b32 s35, s35, s38
    s_add_u32 s40, s40, 1
    s_barrier
    s_waitcnt lgkmcnt(0)
    ds_read_b128 v[20:23], v1 offset:128
    v_fma_f32 v16, v16, s36, -v8
    v_fma_f32 v17, v17, s36, -v8
    v_fma_f32 v18, v18, s36, -v8
    v_fma_f32 v19, v19, s36, -v8
    v_exp_f32 v16, v16
    v_exp_f32 v17, v17
    v_exp_f32 v18, v18
    v_exp_f32 v19, v19
    v_xor_b32 v56, s35, v48
    v_xor_b32 v57, s35, v49
    v_xor_b32 v58, s35, v50
    v_xor_b32 v59, s35, v51
    s_nop 0
    v_add_f32 v9, v9, v16
    v_add_f32 v9, v9, v17
    v_add_f32 v9, v9, v18
    v_add_f32 v9, v9, v19
    v_cvt_pk_bf16_f32 v16, v16, v16
    v_cvt_pk_bf16_f32 v17, v17, v17
    v_cvt_pk_bf16_f32 v18, v18, v18
    v_cvt_pk_bf16_f32 v19, v19, v19
    v_and_b32 v32, v28, v16
    v_and_b32 v33, v29, v16
    v_and_b32 v34, v30, v16
    v_and_b32 v35, v31, v16
    v_and_b32 v36, v28, v17
    v_and_b32 v37, v29, v17
    v_and_b32 v38, v30, v17
    v_and_b32 v39, v31, v17
    v_and_b32 v40, v28, v18
    v_and_b32 v41, v29, v18
    v_and_b32 v42, v30, v18
    v_and_b32 v43, v31, v18
    v_and_b32 v44, v28, v19
    v_and_b32 v45, v29, v19
    v_and_b32 v46, v30, v19
    v_and_b32 v47, v31, v19
    s_waitcnt vmcnt(12)
    s_nop 0
    v_mfma_f32_16x16x32_bf16 v[4:7], v[64:67], v[32:35], v[4:7]
    v_mfma_f32_16x16x32_bf16 v[4:7], v[68:71], v[36:39], v[4:7]
    v_mfma_f32_16x16x32_bf16 v[4:7], v[72:75], v[40:43], v[4:7]
    v_mfma_f32_16x16x32_bf16 v[4:7], v[76:79], v[44:47], v[4:7]
    buffer_load_dwordx4 v[64:67], v56, s[24:27], 0 offen nt
    buffer_load_dwordx4 v[68:71], v57, s[24:27], 0 offen nt
    buffer_load_dwordx4 v[72:75], v58, s[24:27], 0 offen nt
    buffer_load_dwordx4 v[76:79], v59, s[24:27], 0 offen nt
    s_waitcnt lgkmcnt(0)
    ds_read_b128 v[16:19], v1 offset:256
    v_fma_f32 v20, v20, s36, -v8
    v_fma_f32 v21, v21, s36, -v8
    v_fma_f32 v22, v22, s36, -v8
    v_fma_f32 v23, v23, s36, -v8
    v_exp_f32 v20, v20
    v_exp_f32 v21, v21
    v_exp_f32 v22, v22
    v_exp_f32 v23, v23
    s_xor_b32 s35, s35, s31
    v_xor_b32 v60, s35, v48
    v_xor_b32 v61, s35, v49
    v_xor_b32 v62, s35, v50
    v_xor_b32 v63, s35, v51
    s_nop 0
    v_add_f32 v9, v9, v20
    v_add_f32 v9, v9, v21
    v_add_f32 v9, v9, v22
    v_add_f32 v9, v9, v23
    v_cvt_pk_bf16_f32 v20, v20, v20
    v_cvt_pk_bf16_f32 v21, v21, v21
    v_cvt_pk_bf16_f32 v22, v22, v22
    v_cvt_pk_bf16_f32 v23, v23, v23
    v_and_b32 v32, v28, v20
    v_and_b32 v33, v29, v20
    v_and_b32 v34, v30, v20
    v_and_b32 v35, v31, v20
    v_and_b32 v36, v28, v21
    v_and_b32 v37, v29, v21
    v_and_b32 v38, v30, v21
    v_and_b32 v39, v31, v21
    v_and_b32 v40, v28, v22
    v_and_b32 v41, v29, v22
    v_and_b32 v42, v30, v22
    v_and_b32 v43, v31, v22
    v_and_b32 v44, v28, v23
    v_and_b32 v45, v29, v23
    v_and_b32 v46, v30, v23
    v_and_b32 v47, v31, v23
    s_waitcnt vmcnt(12)
    s_nop 0
    v_mfma_f32_16x16x32_bf16 v[4:7], v[80:83], v[32:35], v[4:7]
    v_mfma_f32_16x16x32_bf16 v[4:7], v[84:87], v[36:39], v[4:7]
    v_mfma_f32_16x16x32_bf16 v[4:7], v[88:91], v[40:43], v[4:7]
    v_mfma_f32_16x16x32_bf16 v[4:7], v[92:95], v[44:47], v[4:7]
    buffer_load_dwordx4 v[80:83], v60, s[24:27], 0 offen nt
    buffer_load_dwordx4 v[84:87], v61, s[24:27], 0 offen nt
    buffer_load_dwordx4 v[88:91], v62, s[24:27], 0 offen nt
    buffer_load_dwordx4 v[92:95], v63, s[24:27], 0 offen nt
    s_waitcnt lgkmcnt(0)
    ds_read_b128 v[20:23], v1 offset:384
    v_fma_f32 v16, v16, s36, -v8
    v_fma_f32 v17, v17, s36, -v8
    v_fma_f32 v18, v18, s36, -v8
    v_fma_f32 v19, v19, s36, -v8
    v_exp_f32 v16, v16
    v_exp_f32 v17, v17
    v_exp_f32 v18, v18
    v_exp_f32 v19, v19
    s_xor_b32 s35, s35, s31
    s_xor_b32 s35, s35, 0x202200
    v_xor_b32 v56, s35, v48
    v_xor_b32 v57, s35, v49
    v_xor_b32 v58, s35, v50
    v_xor_b32 v59, s35, v51
    s_nop 0
    v_add_f32 v9, v9, v16
    v_add_f32 v9, v9, v17
    v_add_f32 v9, v9, v18
    v_add_f32 v9, v9, v19
    v_cvt_pk_bf16_f32 v16, v16, v16
    v_cvt_pk_bf16_f32 v17, v17, v17
    v_cvt_pk_bf16_f32 v18, v18, v18
    v_cvt_pk_bf16_f32 v19, v19, v19
    v_and_b32 v32, v28, v16
    v_and_b32 v33, v29, v16
    v_and_b32 v34, v30, v16
    v_and_b32 v35, v31, v16
    v_and_b32 v36, v28, v17
    v_and_b32 v37, v29, v17
    v_and_b32 v38, v30, v17
    v_and_b32 v39, v31, v17
    v_and_b32 v40, v28, v18
    v_and_b32 v41, v29, v18
    v_and_b32 v42, v30, v18
    v_and_b32 v43, v31, v18
    v_and_b32 v44, v28, v19
    v_and_b32 v45, v29, v19
    v_and_b32 v46, v30, v19
    v_and_b32 v47, v31, v19
    s_waitcnt vmcnt(12)
    s_nop 0
    v_mfma_f32_16x16x32_bf16 v[4:7], v[96:99], v[32:35], v[4:7]
    v_mfma_f32_16x16x32_bf16 v[4:7], v[100:103], v[36:39], v[4:7]
    v_mfma_f32_16x16x32_bf16 v[4:7], v[104:107], v[40:43], v[4:7]
    v_mfma_f32_16x16x32_bf16 v[4:7], v[108:111], v[44:47], v[4:7]
    buffer_load_dwordx4 v[96:99], v56, s[24:27], 0 offen nt
    buffer_load_dwordx4 v[100:103], v57, s[24:27], 0 offen nt
    buffer_load_dwordx4 v[104:107], v58, s[24:27], 0 offen nt
    buffer_load_dwordx4 v[108:111], v59, s[24:27], 0 offen nt
    s_waitcnt lgkmcnt(0)
    ds_read_b128 v[16:19], v1 offset:512
    v_fma_f32 v20, v20, s36, -v8
    v_fma_f32 v21, v21, s36, -v8
    v_fma_f32 v22, v22, s36, -v8
    v_fma_f32 v23, v23, s36, -v8
    v_exp_f32 v20, v20
    v_exp_f32 v21, v21
    v_exp_f32 v22, v22
    v_exp_f32 v23, v23
    s_xor_b32 s35, s35, s31
    v_xor_b32 v60, s35, v48
    v_xor_b32 v61, s35, v49
    v_xor_b32 v62, s35, v50
    v_xor_b32 v63, s35, v51
    s_nop 0
    v_add_f32 v9, v9, v20
    v_add_f32 v9, v9, v21
    v_add_f32 v9, v9, v22
    v_add_f32 v9, v9, v23
    v_cvt_pk_bf16_f32 v20, v20, v20
    v_cvt_pk_bf16_f32 v21, v21, v21
    v_cvt_pk_bf16_f32 v22, v22, v22
    v_cvt_pk_bf16_f32 v23, v23, v23
    v_and_b32 v32, v28, v20
    v_and_b32 v33, v29, v20
    v_and_b32 v34, v30, v20
    v_and_b32 v35, v31, v20
    v_and_b32 v36, v28, v21
    v_and_b32 v37, v29, v21
    v_and_b32 v38, v30, v21
    v_and_b32 v39, v31, v21
    v_and_b32 v40, v28, v22
    v_and_b32 v41, v29, v22
    v_and_b32 v42, v30, v22
    v_and_b32 v43, v31, v22
    v_and_b32 v44, v28, v23
    v_and_b32 v45, v29, v23
    v_and_b32 v46, v30, v23
    v_and_b32 v47, v31, v23
    s_waitcnt vmcnt(12)
    s_nop 0
    v_mfma_f32_16x16x32_bf16 v[4:7], v[112:115], v[32:35], v[4:7]
    v_mfma_f32_16x16x32_bf16 v[4:7], v[116:119], v[36:39], v[4:7]
    v_mfma_f32_16x16x32_bf16 v[4:7], v[120:123], v[40:43], v[4:7]
    v_mfma_f32_16x16x32_bf16 v[4:7], v[124:127], v[44:47], v[4:7]
    buffer_load_dwordx4 v[112:115], v60, s[24:27], 0 offen nt
    buffer_load_dwordx4 v[116:119], v61, s[24:27], 0 offen nt
    buffer_load_dwordx4 v[120:123], v62, s[24:27], 0 offen nt
    buffer_load_dwordx4 v[124:127], v63, s[24:27], 0 offen nt
    v_add_u32 v1, 512, v1
    s_add_u32 s37, s37, 1
    s_cmp_lt_u32 s37, 16
    s_cbranch_scc1 L_vloop
    s_waitcnt lgkmcnt(0)
    ds_read_b128 v[20:23], v1 offset:128
    ds_read_b128 v[128:131], v1 offset:256
    ds_read_b128 v[132:135], v1 offset:384
    v_fma_f32 v16, v16, s36, -v8
    v_fma_f32 v17, v17, s36, -v8
    v_fma_f32 v18, v18, s36, -v8
    v_fma_f32 v19, v19, s36, -v8
    v_exp_f32 v16, v16
    v_exp_f32 v17, v17
    v_exp_f32 v18, v18
    v_exp_f32 v19, v19
    s_nop 0
    v_add_f32 v9, v9, v16
    v_add_f32 v9, v9, v17
    v_add_f32 v9, v9, v18
    v_add_f32 v9, v9, v19
    v_cvt_pk_bf16_f32 v16, v16, v16
    v_cvt_pk_bf16_f32 v17, v17, v17
    v_cvt_pk_bf16_f32 v18, v18, v18
    v_cvt_pk_bf16_f32 v19, v19, v19
    v_and_b32 v32, v28, v16
    v_and_b32 v33, v29, v16
    v_and_b32 v34, v30, v16
    v_and_b32 v35, v31, v16
    v_and_b32 v36, v28, v17
    v_and_b32 v37, v29, v17
    v_and_b32 v38, v30, v17
    v_and_b32 v39, v31, v17
    v_and_b32 v40, v28, v18
    v_and_b32 v41, v29, v18
    v_and_b32 v42, v30, v18
    v_and_b32 v43, v31, v18
    v_and_b32 v44, v28, v19
    v_and_b32 v45, v29, v19
    v_and_b32 v46, v30, v19
    v_and_b32 v47, v31, v19
    s_waitcnt vmcnt(12)
    s_nop 0
    v_mfma_f32_16x16x32_bf16 v[4:7], v[64:67], v[32:35], v[4:7]
    v_mfma_f32_16x16x32_bf16 v[4:7], v[68:71], v[36:39], v[4:7]
    v_mfma_f32_16x16x32_bf16 v[4:7], v[72:75], v[40:43], v[4:7]
    v_mfma_f32_16x16x32_bf16 v[4:7], v[76:79], v[44:47], v[4:7]
    s_lshl_b32 s38, s2, 10
    v_lshl_add_u32 v14, v0, 4, s38
    s_lshl_b32 s38, s32, 8
    s_lshl_b32 s45, s33, 4
    s_add_u32 s38, s38, s45
    s_add_u32 s38, s38, 524288
    v_and_b32 v15, 8, v0
    v_add_u32 v15, s38, v15
    v_xor_b32 v48, 0x400, v14
    v_xor_b32 v55, 0x10, v15
    v_xor_b32 v49, 0x800, v14
    v_xor_b32 v56, 0x20, v15
    v_xor_b32 v50, 0xc00, v14
    v_xor_b32 v57, 0x30, v15
    v_xor_b32 v51, 0x1000, v14
    v_xor_b32 v58, 0x40, v15
    v_xor_b32 v52, 0x1400, v14
    v_xor_b32 v59, 0x50, v15
    v_xor_b32 v53, 0x1800, v14
    v_xor_b32 v60, 0x60, v15
    v_xor_b32 v54, 0x1c00, v14
    v_xor_b32 v61, 0x70, v15
    v_bfe_u32 v10, v0, 3, 1
    v_lshl_add_u32 v12, v10, 8, s39
    v_lshrrev_b32 v10, 4, v0
    v_lshl_add_u32 v12, v10, 6, v12
    v_and_b32 v10, 7, v0
    v_lshl_add_u32 v12, v10, 1, v12
    v_lshlrev_b32 v13, 2, v3
    s_waitcnt lgkmcnt(0)
    v_fma_f32 v20, v20, s36, -v8
    v_fma_f32 v21, v21, s36, -v8
    v_fma_f32 v22, v22, s36, -v8
    v_fma_f32 v23, v23, s36, -v8
    v_exp_f32 v20, v20
    v_exp_f32 v21, v21
    v_exp_f32 v22, v22
    v_exp_f32 v23, v23
    s_nop 0
    v_add_f32 v9, v9, v20
    v_add_f32 v9, v9, v21
    v_add_f32 v9, v9, v22
    v_add_f32 v9, v9, v23
    v_cvt_pk_bf16_f32 v20, v20, v20
    v_cvt_pk_bf16_f32 v21, v21, v21
    v_cvt_pk_bf16_f32 v22, v22, v22
    v_cvt_pk_bf16_f32 v23, v23, v23
    v_and_b32 v32, v28, v20
    v_and_b32 v33, v29, v20
    v_and_b32 v34, v30, v20
    v_and_b32 v35, v31, v20
    v_and_b32 v36, v28, v21
    v_and_b32 v37, v29, v21
    v_and_b32 v38, v30, v21
    v_and_b32 v39, v31, v21
    v_and_b32 v40, v28, v22
    v_and_b32 v41, v29, v22
    v_and_b32 v42, v30, v22
    v_and_b32 v43, v31, v22
    v_and_b32 v44, v28, v23
    v_and_b32 v45, v29, v23
    v_and_b32 v46, v30, v23
    v_and_b32 v47, v31, v23
    s_waitcnt vmcnt(8)
    s_nop 0
    v_mfma_f32_16x16x32_bf16 v[4:7], v[80:83], v[32:35], v[4:7]
    v_mfma_f32_16x16x32_bf16 v[4:7], v[84:87], v[36:39], v[4:7]
    v_mfma_f32_16x16x32_bf16 v[4:7], v[88:91], v[40:43], v[4:7]
    v_mfma_f32_16x16x32_bf16 v[4:7], v[92:95], v[44:47], v[4:7]
    s_cmp_lg_u32 s34, 0
    s_cbranch_scc1 L_noel
L_rdy:
    s_cmp_lg_u32 s44, 0
    s_cbranch_scc1 L_go
    s_atomic_add s44, s[18:19], 0 glc
    s_waitcnt lgkmcnt(0)
    s_branch L_rdy
L_go:
    s_atomic_add s42, s[50:51], 0 glc
L_noel:
    v_fma_f32 v128, v128, s36, -v8
    v_fma_f32 v129, v129, s36, -v8
    v_fma_f32 v130, v130, s36, -v8
    v_fma_f32 v131, v131, s36, -v8
    v_exp_f32 v128, v128
    v_exp_f32 v129, v129
    v_exp_f32 v130, v130
    v_exp_f32 v131, v131
    s_nop 0
    v_add_f32 v9, v9, v128
    v_add_f32 v9, v9, v129
    v_add_f32 v9, v9, v130
    v_add_f32 v9, v9, v131
    v_cvt_pk_bf16_f32 v128, v128, v128
    v_cvt_pk_bf16_f32 v129, v129, v129
    v_cvt_pk_bf16_f32 v130, v130, v130
    v_cvt_pk_bf16_f32 v131, v131, v131
    v_and_b32 v32, v28, v128
    v_and_b32 v33, v29, v128
    v_and_b32 v34, v30, v128
    v_and_b32 v35, v31, v128
    v_and_b32 v36, v28, v129
    v_and_b32 v37, v29, v129
    v_and_b32 v38, v30, v129
    v_and_b32 v39, v31, v129
    v_and_b32 v40, v28, v130
    v_and_b32 v41, v29, v130
    v_and_b32 v42, v30, v130
    v_and_b32 v43, v31, v130
    v_and_b32 v44, v28, v131
    v_and_b32 v45, v29, v131
    v_and_b32 v46, v30, v131
    v_and_b32 v47, v31, v131
    s_waitcnt vmcnt(4)
    s_nop 0
    v_mfma_f32_16x16x32_bf16 v[4:7], v[96:99], v[32:35], v[4:7]
    v_mfma_f32_16x16x32_bf16 v[4:7], v[100:103], v[36:39], v[4:7]
    v_mfma_f32_16x16x32_bf16 v[4:7], v[104:107], v[40:43], v[4:7]
    v_mfma_f32_16x16x32_bf16 v[4:7], v[108:111], v[44:47], v[4:7]
    v_fma_f32 v132, v132, s36, -v8
    v_fma_f32 v133, v133, s36, -v8
    v_fma_f32 v134, v134, s36, -v8
    v_fma_f32 v135, v135, s36, -v8
    v_exp_f32 v132, v132
    v_exp_f32 v133, v133
    v_exp_f32 v134, v134
    v_exp_f32 v135, v135
    s_nop 0
    v_add_f32 v9, v9, v132
    v_add_f32 v9, v9, v133
    v_add_f32 v9, v9, v134
    v_add_f32 v9, v9, v135
    v_cvt_pk_bf16_f32 v132, v132, v132
    v_cvt_pk_bf16_f32 v133, v133, v133
    v_cvt_pk_bf16_f32 v134, v134, v134
    v_cvt_pk_bf16_f32 v135, v135, v135
    v_and_b32 v32, v28, v132
    v_and_b32 v33, v29, v132
    v_and_b32 v34, v30, v132
    v_and_b32 v35, v31, v132
    v_and_b32 v36, v28, v133
    v_and_b32 v37, v29, v133
    v_and_b32 v38, v30, v133
    v_and_b32 v39, v31, v133
    v_and_b32 v40, v28, v134
    v_and_b32 v41, v29, v134
    v_and_b32 v42, v30, v134
    v_and_b32 v43, v31, v134
    v_and_b32 v44, v28, v135
    v_and_b32 v45, v29, v135
    v_and_b32 v46, v30, v135
    v_and_b32 v47, v31, v135
    v_mov_b32 v11, v9
    s_nop 1
    v_permlane16_swap_b32 v9, v11
    v_add_f32 v9, v9, v11
    v_mov_b32 v11, v9
    s_nop 1
    v_permlane32_swap_b32 v9, v11
    v_add_f32 v9, v9, v11
    ds_write_b32 v3, v9 offset:6400
    s_waitcnt vmcnt(0)
    v_mfma_f32_16x16x32_bf16 v[4:7], v[112:115], v[32:35], v[4:7]
    v_mfma_f32_16x16x32_bf16 v[4:7], v[116:119], v[36:39], v[4:7]
    v_mfma_f32_16x16x32_bf16 v[4:7], v[120:123], v[40:43], v[4:7]
    v_mfma_f32_16x16x32_bf16 v[4:7], v[124:127], v[44:47], v[4:7]
    s_cmp_eq_u32 s34, 0
    s_cbranch_scc1 L_w0
    s_nop 5
    ds_write_b128 v13, v[4:7] offset:2304
    s_waitcnt lgkmcnt(0)
    s_barrier
    s_endpgm
L_w0:
    s_waitcnt lgkmcnt(0)
    s_cmp_lg_u32 s42, 7
    s_cbranch_scc1 L_nol1
    global_load_dwordx2 v[92:93], v55, s[20:21] sc1
    global_load_dwordx2 v[94:95], v56, s[20:21] sc1
    global_load_dwordx2 v[96:97], v57, s[20:21] sc1
    global_load_dwordx2 v[98:99], v58, s[20:21] sc1
    global_load_dwordx2 v[100:101], v59, s[20:21] sc1
    global_load_dwordx2 v[102:103], v60, s[20:21] sc1
    global_load_dwordx2 v[104:105], v61, s[20:21] sc1
    global_load_dwordx4 v[64:67], v48, s[20:21] sc1
    global_load_dwordx4 v[68:71], v49, s[20:21] sc1
    global_load_dwordx4 v[72:75], v50, s[20:21] sc1
    global_load_dwordx4 v[76:79], v51, s[20:21] sc1
    global_load_dwordx4 v[80:83], v52, s[20:21] sc1
    global_load_dwordx4 v[84:87], v53, s[20:21] sc1
    global_load_dwordx4 v[88:91], v54, s[20:21] sc1
L_nol1:
    s_barrier
    ds_read_b32 v17, v3 offset:6656
    ds_read_b32 v18, v3 offset:6912
    ds_read_b32 v19, v3 offset:7168
    ds_read_b128 v[36:39], v13 offset:3328
    ds_read_b128 v[40:43], v13 offset:4352
    ds_read_b128 v[44:47], v13 offset:5376
    v_min_u32 v8, -2, v8
    s_cmp_eq_u32 s42, 7
    s_waitcnt lgkmcnt(0)
    v_add_f32 v17, v17, v18
    v_add_f32 v9, v9, v19
    v_add_f32 v36, v36, v40
    v_add_f32 v4, v4, v44
    v_add_f32 v37, v37, v41
    v_add_f32 v5, v5, v45
    v_add_f32 v38, v38, v42
    v_add_f32 v6, v6, v46
    v_add_f32 v39, v39, v43
    v_add_f32 v7, v7, v47
    v_add_f32 v4, v4, v36
    v_add_f32 v5, v5, v37
    v_add_f32 v6, v6, v38
    v_add_f32 v7, v7, v39
    v_add_f32 v9, v9, v17
    s_cbranch_scc1 L_fin
    v_min_u32 v4, -2, v4
    v_min_u32 v5, -2, v5
    v_min_u32 v6, -2, v6
    v_min_u32 v7, -2, v7
    v_min_u32 v9, -2, v9
    global_store_dwordx4 v14, v[4:7], s[20:21] sc1
    s_mov_b64 exec, 0x101
    global_store_dwordx2 v15, v[8:9], s[20:21] sc1
    s_endpgm
L_miss:
    global_load_dwordx2 v[92:93], v55, s[20:21] sc1
    global_load_dwordx2 v[94:95], v56, s[20:21] sc1
    global_load_dwordx2 v[96:97], v57, s[20:21] sc1
    global_load_dwordx2 v[98:99], v58, s[20:21] sc1
    global_load_dwordx2 v[100:101], v59, s[20:21] sc1
    global_load_dwordx2 v[102:103], v60, s[20:21] sc1
    global_load_dwordx2 v[104:105], v61, s[20:21] sc1
    global_load_dwordx4 v[64:67], v48, s[20:21] sc1
    global_load_dwordx4 v[68:71], v49, s[20:21] sc1
    global_load_dwordx4 v[72:75], v50, s[20:21] sc1
    global_load_dwordx4 v[76:79], v51, s[20:21] sc1
    global_load_dwordx4 v[80:83], v52, s[20:21] sc1
    global_load_dwordx4 v[84:87], v53, s[20:21] sc1
    global_load_dwordx4 v[88:91], v54, s[20:21] sc1
L_fin:
    s_waitcnt vmcnt(7)
    v_max3_u32 v16, v92, v94, v96
    v_max3_u32 v16, v16, v98, v100
    v_max3_u32 v16, v16, v102, v104
    v_cmp_eq_u32 vcc, -1, v16
    v_max3_f32 v17, v8, v92, v94
    v_max3_f32 v17, v17, v96, v98
    v_max3_f32 v17, v17, v100, v102
    v_max_f32 v17, v17, v104
    s_cbranch_vccnz L_miss
    v_sub_f32 v18, v8, v17
    v_sub_f32 v92, v92, v17
    v_sub_f32 v94, v94, v17
    v_sub_f32 v96, v96, v17
    v_sub_f32 v98, v98, v17
    v_sub_f32 v100, v100, v17
    v_sub_f32 v102, v102, v17
    v_sub_f32 v104, v104, v17
    v_exp_f32 v18, v18
    v_exp_f32 v92, v92
    v_exp_f32 v94, v94
    v_exp_f32 v96, v96
    v_exp_f32 v98, v98
    v_exp_f32 v100, v100
    v_exp_f32 v102, v102
    v_exp_f32 v104, v104
    v_mul_f32 v19, v18, v9
    v_mul_f32 v32, v18, v4
    v_mul_f32 v33, v18, v5
    v_mul_f32 v34, v18, v6
    v_mul_f32 v35, v18, v7
    v_fmac_f32 v19, v92, v93
    v_fmac_f32 v19, v94, v95
    v_fmac_f32 v19, v96, v97
    v_fmac_f32 v19, v98, v99
    v_fmac_f32 v19, v100, v101
    v_fmac_f32 v19, v102, v103
    v_fmac_f32 v19, v104, v105
    v_rcp_f32 v19, v19
    s_waitcnt vmcnt(0)
    v_fmac_f32 v32, v92, v64
    v_fmac_f32 v33, v92, v65
    v_fmac_f32 v34, v92, v66
    v_fmac_f32 v35, v92, v67
    v_fmac_f32 v32, v94, v68
    v_fmac_f32 v33, v94, v69
    v_fmac_f32 v34, v94, v70
    v_fmac_f32 v35, v94, v71
    v_fmac_f32 v32, v96, v72
    v_fmac_f32 v33, v96, v73
    v_fmac_f32 v34, v96, v74
    v_fmac_f32 v35, v96, v75
    v_fmac_f32 v32, v98, v76
    v_fmac_f32 v33, v98, v77
    v_fmac_f32 v34, v98, v78
    v_fmac_f32 v35, v98, v79
    v_fmac_f32 v32, v100, v80
    v_fmac_f32 v33, v100, v81
    v_fmac_f32 v34, v100, v82
    v_fmac_f32 v35, v100, v83
    v_fmac_f32 v32, v102, v84
    v_fmac_f32 v33, v102, v85
    v_fmac_f32 v34, v102, v86
    v_fmac_f32 v35, v102, v87
    v_fmac_f32 v32, v104, v88
    v_fmac_f32 v33, v104, v89
    v_fmac_f32 v34, v104, v90
    v_fmac_f32 v35, v104, v91
    v_mul_f32 v32, v32, v19
    v_mul_f32 v33, v33, v19
    v_mul_f32 v34, v34, v19
    v_mul_f32 v35, v35, v19
    v_cmp_u_f32 vcc, v32, v33
    v_cmp_u_f32 s[28:29], v34, v35
    v_cvt_pk_bf16_f32 v32, v32, v33
    v_cvt_pk_bf16_f32 v34, v34, v35
    s_nop 0
    s_or_b64 s[28:29], s[28:29], vcc
    s_cbranch_scc1 L_nan
L_store:
    global_store_short v12, v32, s[16:17]
    global_store_short_d16_hi v12, v32, s[16:17] offset:16
    global_store_short v12, v34, s[16:17] offset:32
    global_store_short_d16_hi v12, v34, s[16:17] offset:48
    s_endpgm
L_nan:
    v_max3_u32 v16, v93, v95, v97
    v_max3_u32 v16, v16, v99, v101
    v_max3_u32 v16, v16, v103, v105
    v_max3_u32 v16, v16, v64, v65
    v_max3_u32 v16, v16, v66, v67
    v_max3_u32 v16, v16, v68, v69
    v_max3_u32 v16, v16, v70, v71
    v_max3_u32 v16, v16, v72, v73
    v_max3_u32 v16, v16, v74, v75
    v_max3_u32 v16, v16, v76, v77
    v_max3_u32 v16, v16, v78, v79
    v_max3_u32 v16, v16, v80, v81
    v_max3_u32 v16, v16, v82, v83
    v_max3_u32 v16, v16, v84, v85
    v_max3_u32 v16, v16, v86, v87
    v_max3_u32 v16, v16, v88, v89
    v_max3_u32 v16, v16, v90, v91
    v_cmp_eq_u32 vcc, -1, v16
    s_nop 4
    s_cbranch_vccnz L_miss
    s_branch L_store
L_end:
    s_endpgm
.section .rodata,"a"
.p2align 6
.amdhsa_kernel standalone__tree_speculative_verify_tree_attention_over_candidate_token_tree__decode_kernel
  .amdhsa_next_free_vgpr 136
  .amdhsa_next_free_sgpr 52
  .amdhsa_accum_offset 136
  .amdhsa_group_segment_fixed_size 0
  .amdhsa_kernarg_size 72
  .amdhsa_user_sgpr_count 2
  .amdhsa_user_sgpr_kernarg_segment_ptr 1
  .amdhsa_system_sgpr_workgroup_id_x 1
  .amdhsa_float_denorm_mode_32 3
.end_amdhsa_kernel
```
